```python
import torch

def _softmax(x, axis=-1):
    return torch.softmax(x, dim=axis)
def _gelu(x):
    return torch.nn.functional.gelu(x, approximate="tanh")
def _silu(x):
    return torch.nn.functional.silu(x)
def _sigmoid(x):
    return torch.sigmoid(x)
def _layernorm(x, axis=-1, eps=1e-5):
    m = x.mean(dim=axis, keepdim=True)
    v = x.var(dim=axis, keepdim=True, unbiased=False)
    return (x - m) / torch.sqrt(v + eps)
def _scatter_add(tgt, idx, src, axis=0):
    return tgt.clone().index_add_(axis, idx, src)
def _segment_sum(src, seg, n):
    out = torch.zeros((n,) + src.shape[1:], dtype=src.dtype)
    return out.index_add_(0, seg, src)
def _pad(x, pw):
    flat = tuple(v for pair in reversed(pw) for v in pair)
    return torch.nn.functional.pad(x, flat)

kernel_name = 'standalone__softmax_full_bidir__sampling'

def setup_inputs():

    _w = (lambda a: (lambda t: t.to(torch.bfloat16) if t.is_floating_point() else t)(torch.as_tensor(a)))
    B, H, Sq, Skv, Dh = 16, 32, 1, 2048, 128
    return {
        "q": _w((lambda *s: torch.randn(*s, dtype=torch.bfloat16) * 0.8)(B, H, Sq, Dh)),
        "k": _w((lambda *s: torch.randn(*s, dtype=torch.bfloat16) * 0.8)(B, H, Skv, Dh)),
        "v": _w((lambda *s: torch.randn(*s, dtype=torch.bfloat16) * 0.05)(B, H, Skv, Dh)),
    }

def reference(q, k, v):
    scale = q.shape[-1] ** -0.5
    scores = torch.einsum('bhqd,bhkd->bhqk', q, k) * scale
    attn = _softmax(scores, axis=-1)
    return torch.einsum('bhqk,bhkd->bhqd', attn, v)
```

```asm
; @launch grid=(256,1,1) block=(256,1,1) lds=98304
.amdgcn_target "amdgcn-amd-amdhsa--gfx950"
.text
.globl standalone__softmax_full_bidir__sampling_kernel
.p2align 8
.type standalone__softmax_full_bidir__sampling_kernel,@function
standalone__softmax_full_bidir__sampling_kernel:
    s_load_dwordx2 s[4:5], s[0:1], 8
    s_load_dwordx2 s[12:13], s[0:1], 0
    s_load_dwordx4 s[20:23], s[0:1], 8
    s_load_dwordx2 s[16:17], s[0:1], 24
    s_load_dwordx2 s[56:57], s[0:1], 32
    s_memrealtime s[42:43]
    s_cmpk_ge_u32 s2, 256
    s_cbranch_scc1 L_end
    v_and_b32 v20, 0xc0, v0
    v_and_b32 v21, 63, v0
    v_lshlrev_b32 v20, 6, v20
    v_lshl_add_u32 v1, v21, 4, v20
    v_and_b32 v3, 15, v0
    v_xor_b32 v2, 0x2000, v1
    v_lshlrev_b32 v3, 4, v3
    s_lshl_b32 s32, s2, 20
    s_lshl_b32 s36, s2, 9
    s_brev_b32 s6, 8
    s_mov_b32 s7, 0x20000
    s_mov_b32 s14, 0x20000
    s_mov_b32 s15, 0x20000
    s_mov_b32 s26, s32
    s_add_u32 s28, s26, 32768
    s_waitcnt lgkmcnt(0)
    buffer_load_dwordx4 v[60:63], v1, s[4:7], s26 offen offset:0 nt
    buffer_load_dwordx4 v[4:7], v3, s[12:15], s36 offen
    buffer_load_dwordx4 v[64:67], v1, s[4:7], s26 offen offset:1024 nt
    buffer_load_dwordx4 v[68:71], v1, s[4:7], s26 offen offset:2048 nt
    buffer_load_dwordx4 v[72:75], v1, s[4:7], s26 offen offset:3072 nt
    buffer_load_dwordx4 v[76:79], v2, s[4:7], s28 offen offset:0 nt
    buffer_load_dwordx4 v[80:83], v2, s[4:7], s28 offen offset:1024 nt
    v_lshrrev_b32 v20, 6, v0
    v_mov_b32 v0, v21
    v_readfirstlane_b32 s30, v20
    s_brev_b32 s10, 8
    s_mov_b32 s11, 0x20000
    s_mov_b32 s18, 0x20000
    s_mov_b32 s19, 0x20000
    s_mov_b32 s31, s32
    v_mov_b32 v8, 0
    v_mov_b32 v9, 0
    v_mov_b32 v10, 0
    v_mov_b32 v11, 0
    v_mov_b32 v12, 0
    v_mov_b32 v13, 0
    v_mov_b32 v14, 0
    v_mov_b32 v15, 0
    v_mov_b32 v58, 0
    v_mov_b32 v47, 0
    s_mov_b32 s35, 0x3e0293ee
    s_mov_b32 s38, 0xaaaaaaaa
    s_mov_b32 s39, 0xaaaaaaaa
    s_mov_b32 s40, 0xcccccccc
    s_mov_b32 s41, 0xcccccccc
    s_mov_b32 s37, 0
    s_mov_b32 s29, 0
    s_mov_b32 s49, 0
    s_mov_b32 s51, 0
    v_and_b32 v20, 15, v0
    v_lshlrev_b32 v20, 4, v20
    v_lshrrev_b32 v22, 4, v0
    v_lshl_add_u32 v56, v22, 2, v20
    v_lshlrev_b32 v57, 3, v0
    s_cmp_lt_u32 s2, 8
    s_cselect_b32 s46, 2, 0
    s_cmp_eq_u32 s30, 0
    s_cselect_b32 s46, s46, 0
    s_mov_b32 s44, 0
    s_mov_b32 s47, 0
    s_movk_i32 s58, 256
    s_mov_b32 s59, 0x20000
    s_mov_b64 vcc, 0
    ds_write_b128 v58, v[8:11] offset:4224
    s_waitcnt lgkmcnt(0)
    s_lshl_b32 s45, s42, 8
    s_add_u32 s45, s45, 268435456
    s_mov_b32 s52, s45
    s_mov_b32 s53, 0
    s_barrier
L_k:
    s_memrealtime s[42:43]
    s_cbranch_vccnz L_pk0
    s_waitcnt vmcnt(4)
L_pk0:
    s_waitcnt vmcnt(5)
    s_add_u32 s28, s26, 32768
    buffer_load_dwordx4 v[84:87], v2, s[4:7], s28 offen offset:2048 nt
    v_dot2_f32_bf16 v24, v60, v4, 0
    v_dot2_f32_bf16 v24, v61, v5, v24
    v_dot2_f32_bf16 v24, v62, v6, v24
    v_dot2_f32_bf16 v24, v63, v7, v24
    v_add_f32_dpp v38, v38, v38 row_ror:8 row_mask:0xf bank_mask:0x3
    v_add_f32_dpp v38, v39, v39 row_ror:8 row_mask:0xf bank_mask:0xc
    s_cbranch_vccnz L_pk1
    s_waitcnt vmcnt(4)
L_pk1:
    s_waitcnt vmcnt(5)
    buffer_load_dwordx4 v[88:91], v2, s[4:7], s28 offen offset:3072 nt
    v_dot2_f32_bf16 v25, v64, v4, 0
    v_dot2_f32_bf16 v25, v65, v5, v25
    v_dot2_f32_bf16 v25, v66, v6, v25
    v_dot2_f32_bf16 v25, v67, v7, v25
    v_add_f32_dpp v43, v36, v36 row_half_mirror row_mask:0xf bank_mask:0x5
    v_add_f32_dpp v43, v38, v38 row_half_mirror row_mask:0xf bank_mask:0xa
    v_mov_b32 v48, v49
    v_mov_b32 v49, v50
    v_mov_b32 v50, v51
    v_mov_b32 v51, v52
    v_mov_b32 v52, v53
    v_mov_b32 v53, v54
    v_mov_b32 v54, v55
    s_cbranch_vccnz L_pk2
    s_waitcnt vmcnt(4)
L_pk2:
    s_waitcnt vmcnt(5)
    s_add_u32 s28, s26, 65536
    buffer_load_dwordx4 v[60:63], v1, s[4:7], s28 offen offset:0 nt
    v_dot2_f32_bf16 v26, v68, v4, 0
    v_dot2_f32_bf16 v26, v69, v5, v26
    v_dot2_f32_bf16 v26, v70, v6, v26
    v_dot2_f32_bf16 v26, v71, v7, v26
    v_add_f32_dpp v24, v24, v24 row_ror:8 row_mask:0xf bank_mask:0x3
    v_add_f32_dpp v24, v25, v25 row_ror:8 row_mask:0xf bank_mask:0xc
    v_add_f32_dpp v42, v42, v42 quad_perm:[2,3,0,1] row_mask:0xf bank_mask:0xf
    v_add_f32_dpp v43, v43, v43 quad_perm:[2,3,0,1] row_mask:0xf bank_mask:0xf
    v_cndmask_b32 v45, v42, v43, s[40:41]
    s_cbranch_vccnz L_pk3
    s_waitcnt vmcnt(4)
L_pk3:
    s_waitcnt vmcnt(5)
    buffer_load_dwordx4 v[64:67], v1, s[4:7], s28 offen offset:1024 nt
    v_dot2_f32_bf16 v27, v72, v4, 0
    v_dot2_f32_bf16 v27, v73, v5, v27
    v_dot2_f32_bf16 v27, v74, v6, v27
    v_dot2_f32_bf16 v27, v75, v7, v27
    v_add_f32_dpp v44, v44, v44 quad_perm:[1,0,3,2] row_mask:0xf bank_mask:0xf
    v_add_f32_dpp v45, v45, v45 quad_perm:[1,0,3,2] row_mask:0xf bank_mask:0xf
    v_cndmask_b32 v55, v44, v45, s[38:39]
    s_add_u32 s29, s29, 1
    s_and_b32 s34, s29, 3
    s_lshl_b32 s27, s34, 17
    s_and_b32 s34, s29, 4
    s_lshl_b32 s34, s34, 12
    s_add_u32 s27, s27, s34
    s_cmp_eq_u32 s29, 8
    s_cselect_b64 s[8:9], s[22:23], s[20:21]
    s_cselect_b32 s34, s31, s32
    s_add_u32 s27, s27, s34
    s_cbranch_vccnz L_pk4
    s_waitcnt vmcnt(4)
L_pk4:
    s_waitcnt vmcnt(5)
    buffer_load_dwordx4 v[68:71], v1, s[4:7], s28 offen offset:2048 nt
    v_dot2_f32_bf16 v28, v76, v4, 0
    v_dot2_f32_bf16 v28, v77, v5, v28
    v_dot2_f32_bf16 v28, v78, v6, v28
    v_dot2_f32_bf16 v28, v79, v7, v28
    v_add_f32_dpp v26, v26, v26 row_ror:8 row_mask:0xf bank_mask:0x3
    v_add_f32_dpp v26, v27, v27 row_ror:8 row_mask:0xf bank_mask:0xc
    s_cbranch_vccnz L_pk5
    s_waitcnt vmcnt(4)
L_pk5:
    s_waitcnt vmcnt(5)
    buffer_load_dwordx4 v[72:75], v1, s[4:7], s28 offen offset:3072 nt
    v_dot2_f32_bf16 v29, v80, v4, 0
    v_dot2_f32_bf16 v29, v81, v5, v29
    v_dot2_f32_bf16 v29, v82, v6, v29
    v_dot2_f32_bf16 v29, v83, v7, v29
    v_add_f32_dpp v40, v24, v24 row_half_mirror row_mask:0xf bank_mask:0x5
    v_add_f32_dpp v40, v26, v26 row_half_mirror row_mask:0xf bank_mask:0xa
    s_cbranch_vccnz L_pk6
    s_waitcnt vmcnt(4)
L_pk6:
    s_waitcnt vmcnt(5)
    s_add_u32 s28, s26, 98304
    buffer_load_dwordx4 v[76:79], v2, s[4:7], s28 offen offset:0 nt
    v_dot2_f32_bf16 v30, v84, v4, 0
    v_dot2_f32_bf16 v30, v85, v5, v30
    v_dot2_f32_bf16 v30, v86, v6, v30
    v_dot2_f32_bf16 v30, v87, v7, v30
    v_add_f32_dpp v28, v28, v28 row_ror:8 row_mask:0xf bank_mask:0x3
    v_add_f32_dpp v28, v29, v29 row_ror:8 row_mask:0xf bank_mask:0xc
    s_cbranch_vccnz L_pk7
    s_waitcnt vmcnt(4)
L_pk7:
    s_waitcnt vmcnt(5)
    buffer_load_dwordx4 v[80:83], v2, s[4:7], s28 offen offset:1024 nt
    v_dot2_f32_bf16 v31, v88, v4, 0
    v_dot2_f32_bf16 v31, v89, v5, v31
    v_dot2_f32_bf16 v31, v90, v6, v31
    v_dot2_f32_bf16 v31, v91, v7, v31
    s_waitcnt lgkmcnt(0)
    s_sub_u32 s48, s42, s44
    s_add_u32 s44, s44, 218
    s_cmp_lg_u32 s29, s46
    s_cbranch_scc1 L_ak
    s_lshl_b32 s33, s48, 5
    s_add_u32 s33, s33, 1
    s_atomic_add s33, s[56:57], s47
L_ak:
    s_cbranch_vccnz L_pk8
    s_waitcnt vmcnt(4)
L_pk8:
    s_waitcnt vmcnt(5)
    buffer_load_dwordx4 v[84:87], v2, s[4:7], s28 offen offset:2048 nt
    v_dot2_f32_bf16 v32, v60, v4, 0
    v_dot2_f32_bf16 v32, v61, v5, v32
    v_dot2_f32_bf16 v32, v62, v6, v32
    v_dot2_f32_bf16 v32, v63, v7, v32
    v_add_f32_dpp v30, v30, v30 row_ror:8 row_mask:0xf bank_mask:0x3
    v_add_f32_dpp v30, v31, v31 row_ror:8 row_mask:0xf bank_mask:0xc
    s_cbranch_vccnz L_pk9
    s_waitcnt vmcnt(4)
L_pk9:
    s_waitcnt vmcnt(5)
    buffer_load_dwordx4 v[88:91], v2, s[4:7], s28 offen offset:3072 nt
    v_dot2_f32_bf16 v33, v64, v4, 0
    v_dot2_f32_bf16 v33, v65, v5, v33
    v_dot2_f32_bf16 v33, v66, v6, v33
    v_dot2_f32_bf16 v33, v67, v7, v33
    v_add_f32_dpp v41, v28, v28 row_half_mirror row_mask:0xf bank_mask:0x5
    v_add_f32_dpp v41, v30, v30 row_half_mirror row_mask:0xf bank_mask:0xa
    s_cbranch_vccnz L_pk10
    s_waitcnt vmcnt(4)
L_pk10:
    s_waitcnt vmcnt(5)
    buffer_load_dwordx4 v[60:63], v1, s[8:11], s27 offen offset:0 nt
    v_dot2_f32_bf16 v34, v68, v4, 0
    v_dot2_f32_bf16 v34, v69, v5, v34
    v_dot2_f32_bf16 v34, v70, v6, v34
    v_dot2_f32_bf16 v34, v71, v7, v34
    v_add_f32_dpp v32, v32, v32 row_ror:8 row_mask:0xf bank_mask:0x3
    v_add_f32_dpp v32, v33, v33 row_ror:8 row_mask:0xf bank_mask:0xc
    v_add_f32_dpp v40, v40, v40 quad_perm:[2,3,0,1] row_mask:0xf bank_mask:0xf
    v_add_f32_dpp v41, v41, v41 quad_perm:[2,3,0,1] row_mask:0xf bank_mask:0xf
    v_cndmask_b32 v44, v40, v41, s[40:41]
    s_cbranch_vccnz L_pk11
    s_waitcnt vmcnt(4)
L_pk11:
    s_waitcnt vmcnt(5)
    buffer_load_dwordx4 v[64:67], v1, s[8:11], s27 offen offset:1024 nt
    v_dot2_f32_bf16 v35, v72, v4, 0
    v_dot2_f32_bf16 v35, v73, v5, v35
    v_dot2_f32_bf16 v35, v74, v6, v35
    v_dot2_f32_bf16 v35, v75, v7, v35
    s_cmp_lg_u32 s29, 4
    s_cbranch_scc1 L_bk
    buffer_load_dword v47, off, s[56:59], s47 sc1
    s_add_u32 s47, s47, 64
L_bk:
    s_cmp_lg_u32 s29, 5
    s_cbranch_scc1 L_ck
    v_readfirstlane_b32 s33, v47
    s_and_b32 s34, s33, 31
    s_cmp_eq_u32 s34, 8
    s_cbranch_scc0 L_ck
    s_sub_u32 s34, s33, s52
    s_ashr_i32 s34, s34, 3
    s_cmp_lt_i32 s34, -16384
    s_cselect_b32 s34, 0, s34
    s_max_i32 s34, s34, -2560
    s_min_i32 s53, s34, 2560
    s_mov_b32 s52, s33
    s_mul_i32 s34, s53, 2
    s_add_u32 s45, s33, s34
L_ck:
    s_add_u32 s45, s45, s53
    s_lshl_b32 s48, s48, 8
    s_sub_u32 s48, s48, s45
    s_cmp_gt_i32 s48, 6400
    s_cselect_b64 vcc, -1, 0
    s_cbranch_vccnz L_pk12
    s_waitcnt vmcnt(4)
L_pk12:
    s_waitcnt vmcnt(5)
    buffer_load_dwordx4 v[68:71], v1, s[8:11], s27 offen offset:2048 nt
    v_dot2_f32_bf16 v36, v76, v4, 0
    v_dot2_f32_bf16 v36, v77, v5, v36
    v_dot2_f32_bf16 v36, v78, v6, v36
    v_dot2_f32_bf16 v36, v79, v7, v36
    v_add_f32_dpp v34, v34, v34 row_ror:8 row_mask:0xf bank_mask:0x3
    v_add_f32_dpp v34, v35, v35 row_ror:8 row_mask:0xf bank_mask:0xc
    s_cbranch_vccnz L_pk13
    s_waitcnt vmcnt(4)
L_pk13:
    s_waitcnt vmcnt(5)
    buffer_load_dwordx4 v[72:75], v1, s[8:11], s27 offen offset:3072 nt
    v_dot2_f32_bf16 v37, v80, v4, 0
    v_dot2_f32_bf16 v37, v81, v5, v37
    v_dot2_f32_bf16 v37, v82, v6, v37
    v_dot2_f32_bf16 v37, v83, v7, v37
    v_add_f32_dpp v42, v32, v32 row_half_mirror row_mask:0xf bank_mask:0x5
    v_add_f32_dpp v42, v34, v34 row_half_mirror row_mask:0xf bank_mask:0xa
    s_cbranch_vccnz L_pk14
    s_waitcnt vmcnt(4)
L_pk14:
    s_waitcnt vmcnt(5)
    s_add_u32 s28, s27, 32768
    buffer_load_dwordx4 v[76:79], v2, s[8:11], s28 offen offset:0 nt
    v_dot2_f32_bf16 v38, v84, v4, 0
    v_dot2_f32_bf16 v38, v85, v5, v38
    v_dot2_f32_bf16 v38, v86, v6, v38
    v_dot2_f32_bf16 v38, v87, v7, v38
    v_add_f32_dpp v36, v36, v36 row_ror:8 row_mask:0xf bank_mask:0x3
    v_add_f32_dpp v36, v37, v37 row_ror:8 row_mask:0xf bank_mask:0xc
    s_cbranch_vccnz L_pk15
    s_waitcnt vmcnt(4)
L_pk15:
    s_waitcnt vmcnt(5)
    buffer_load_dwordx4 v[80:83], v2, s[8:11], s28 offen offset:1024 nt
    v_dot2_f32_bf16 v39, v88, v4, 0
    v_dot2_f32_bf16 v39, v89, v5, v39
    v_dot2_f32_bf16 v39, v90, v6, v39
    v_dot2_f32_bf16 v39, v91, v7, v39
    s_mov_b64 s[4:5], s[8:9]
    s_mov_b32 s26, s27
    s_cmp_lg_u32 s29, 8
    s_cbranch_scc1 L_k
    s_add_u32 s33, s36, 256
    buffer_load_dwordx4 v[4:7], v3, s[12:15], s33 offen
    v_add_f32_dpp v38, v38, v38 row_ror:8 row_mask:0xf bank_mask:0x3
    v_add_f32_dpp v38, v39, v39 row_ror:8 row_mask:0xf bank_mask:0xc
    v_max3_f32 v20, v49, v50, v51
    v_max3_f32 v21, v52, v53, v54
    v_add_f32_dpp v43, v36, v36 row_half_mirror row_mask:0xf bank_mask:0x5
    v_add_f32_dpp v43, v38, v38 row_half_mirror row_mask:0xf bank_mask:0xa
    v_max3_f32 v20, v20, v21, v55
    s_mov_b32 s29, 0
    v_add_f32_dpp v42, v42, v42 quad_perm:[2,3,0,1] row_mask:0xf bank_mask:0xf
    v_add_f32_dpp v43, v43, v43 quad_perm:[2,3,0,1] row_mask:0xf bank_mask:0xf
    v_cndmask_b32 v45, v42, v43, s[40:41]
    s_add_u32 s31, s31, 524288
    s_cmp_lg_u32 s37, 0
    v_add_f32_dpp v44, v44, v44 quad_perm:[1,0,3,2] row_mask:0xf bank_mask:0xf
    v_add_f32_dpp v45, v45, v45 quad_perm:[1,0,3,2] row_mask:0xf bank_mask:0xf
    s_cselect_b32 s31, 0x20000000, s31
    v_cndmask_b32 v48, v44, v45, s[38:39]
    v_max_f32 v20, v20, v48
    s_nop 1
    v_max_f32_dpp v20, v20, v20 row_ror:8 row_mask:0xf bank_mask:0xf
    s_nop 1
    v_max_f32_dpp v20, v20, v20 row_ror:4 row_mask:0xf bank_mask:0xf
    s_nop 1
    v_max_f32_dpp v20, v20, v20 row_ror:2 row_mask:0xf bank_mask:0xf
    s_nop 1
    v_max_f32_dpp v20, v20, v20 row_ror:1 row_mask:0xf bank_mask:0xf
    v_mov_b32 v21, v20
    s_nop 1
    v_permlane32_swap_b32 v20, v21
    s_nop 0
    v_max_f32 v20, v20, v21
    v_mov_b32 v21, v20
    s_nop 1
    v_permlane16_swap_b32 v20, v21
    s_nop 0
    v_max_f32 v20, v20, v21
    v_mul_f32 v16, s35, v20
    v_fma_f32 v49, v49, s35, -v16
    v_fma_f32 v50, v50, s35, -v16
    v_fma_f32 v51, v51, s35, -v16
    v_fma_f32 v52, v52, s35, -v16
    v_fma_f32 v53, v53, s35, -v16
    v_fma_f32 v54, v54, s35, -v16
    v_fma_f32 v55, v55, s35, -v16
    v_fma_f32 v48, v48, s35, -v16
    v_exp_f32 v49, v49
    v_exp_f32 v50, v50
    v_exp_f32 v51, v51
    v_exp_f32 v52, v52
    v_exp_f32 v53, v53
    v_exp_f32 v54, v54
    v_exp_f32 v55, v55
    v_exp_f32 v48, v48
    s_nop 0
    v_cvt_pk_bf16_f32 v24, 0, v49
    v_cvt_pk_bf16_f32 v25, 0, v50
    v_cvt_pk_bf16_f32 v26, 0, v51
    v_cvt_pk_bf16_f32 v27, 0, v52
    v_cvt_pk_bf16_f32 v28, 0, v53
    v_cvt_pk_bf16_f32 v29, 0, v54
    v_cvt_pk_bf16_f32 v30, 0, v55
    v_cvt_pk_bf16_f32 v31, 0, v48
L_v:
    s_memrealtime s[42:43]
    v_mov_b32 v19, v24
    v_lshrrev_b32 v18, 16, v24
    s_cbranch_vccnz L_pv0
    s_waitcnt vmcnt(4)
L_pv0:
    s_waitcnt vmcnt(5)
    s_add_u32 s28, s26, 32768
    buffer_load_dwordx4 v[84:87], v2, s[4:7], s28 offen offset:2048 nt
    v_dot2c_f32_bf16_dpp v8, v18, v60 row_newbcast:0 row_mask:0xf bank_mask:0xf
    v_dot2c_f32_bf16_dpp v9, v19, v60 row_newbcast:0 row_mask:0xf bank_mask:0xf
    v_dot2c_f32_bf16_dpp v10, v18, v61 row_newbcast:0 row_mask:0xf bank_mask:0xf
    v_dot2c_f32_bf16_dpp v11, v19, v61 row_newbcast:0 row_mask:0xf bank_mask:0xf
    v_dot2c_f32_bf16_dpp v12, v18, v62 row_newbcast:0 row_mask:0xf bank_mask:0xf
    v_dot2c_f32_bf16_dpp v13, v19, v62 row_newbcast:0 row_mask:0xf bank_mask:0xf
    v_dot2c_f32_bf16_dpp v14, v18, v63 row_newbcast:0 row_mask:0xf bank_mask:0xf
    v_dot2c_f32_bf16_dpp v15, v19, v63 row_newbcast:0 row_mask:0xf bank_mask:0xf
    s_cbranch_vccnz L_pv1
    s_waitcnt vmcnt(4)
L_pv1:
    s_waitcnt vmcnt(5)
    buffer_load_dwordx4 v[88:91], v2, s[4:7], s28 offen offset:3072 nt
    v_dot2c_f32_bf16_dpp v8, v18, v64 row_newbcast:8 row_mask:0xf bank_mask:0xf
    v_dot2c_f32_bf16_dpp v9, v19, v64 row_newbcast:8 row_mask:0xf bank_mask:0xf
    v_dot2c_f32_bf16_dpp v10, v18, v65 row_newbcast:8 row_mask:0xf bank_mask:0xf
    v_dot2c_f32_bf16_dpp v11, v19, v65 row_newbcast:8 row_mask:0xf bank_mask:0xf
    v_dot2c_f32_bf16_dpp v12, v18, v66 row_newbcast:8 row_mask:0xf bank_mask:0xf
    v_dot2c_f32_bf16_dpp v13, v19, v66 row_newbcast:8 row_mask:0xf bank_mask:0xf
    v_dot2c_f32_bf16_dpp v14, v18, v67 row_newbcast:8 row_mask:0xf bank_mask:0xf
    v_dot2c_f32_bf16_dpp v15, v19, v67 row_newbcast:8 row_mask:0xf bank_mask:0xf
    v_mov_b32 v24, v25
    v_mov_b32 v25, v26
    v_mov_b32 v26, v27
    v_mov_b32 v27, v28
    v_mov_b32 v28, v29
    v_mov_b32 v29, v30
    v_mov_b32 v30, v31
    s_cbranch_vccnz L_pv2
    s_waitcnt vmcnt(4)
L_pv2:
    s_waitcnt vmcnt(5)
    s_add_u32 s28, s26, 65536
    buffer_load_dwordx4 v[60:63], v1, s[4:7], s28 offen offset:0 nt
    v_dot2c_f32_bf16_dpp v8, v18, v68 row_newbcast:4 row_mask:0xf bank_mask:0xf
    v_dot2c_f32_bf16_dpp v9, v19, v68 row_newbcast:4 row_mask:0xf bank_mask:0xf
    v_dot2c_f32_bf16_dpp v10, v18, v69 row_newbcast:4 row_mask:0xf bank_mask:0xf
    v_dot2c_f32_bf16_dpp v11, v19, v69 row_newbcast:4 row_mask:0xf bank_mask:0xf
    v_dot2c_f32_bf16_dpp v12, v18, v70 row_newbcast:4 row_mask:0xf bank_mask:0xf
    v_dot2c_f32_bf16_dpp v13, v19, v70 row_newbcast:4 row_mask:0xf bank_mask:0xf
    v_dot2c_f32_bf16_dpp v14, v18, v71 row_newbcast:4 row_mask:0xf bank_mask:0xf
    v_dot2c_f32_bf16_dpp v15, v19, v71 row_newbcast:4 row_mask:0xf bank_mask:0xf
    s_add_u32 s29, s29, 1
    s_and_b32 s34, s29, 3
    s_lshl_b32 s27, s34, 17
    s_and_b32 s34, s29, 4
    s_lshl_b32 s34, s34, 12
    s_add_u32 s27, s27, s34
    s_cmp_eq_u32 s29, 8
    s_cselect_b64 s[8:9], s[20:21], s[22:23]
    s_cselect_b32 s34, s31, s32
    s_add_u32 s27, s27, s34
    s_cbranch_vccnz L_pv3
    s_waitcnt vmcnt(4)
L_pv3:
    s_waitcnt vmcnt(5)
    buffer_load_dwordx4 v[64:67], v1, s[4:7], s28 offen offset:1024 nt
    v_dot2c_f32_bf16_dpp v8, v18, v72 row_newbcast:12 row_mask:0xf bank_mask:0xf
    v_dot2c_f32_bf16_dpp v9, v19, v72 row_newbcast:12 row_mask:0xf bank_mask:0xf
    v_dot2c_f32_bf16_dpp v10, v18, v73 row_newbcast:12 row_mask:0xf bank_mask:0xf
    v_dot2c_f32_bf16_dpp v11, v19, v73 row_newbcast:12 row_mask:0xf bank_mask:0xf
    v_dot2c_f32_bf16_dpp v12, v18, v74 row_newbcast:12 row_mask:0xf bank_mask:0xf
    v_dot2c_f32_bf16_dpp v13, v19, v74 row_newbcast:12 row_mask:0xf bank_mask:0xf
    v_dot2c_f32_bf16_dpp v14, v18, v75 row_newbcast:12 row_mask:0xf bank_mask:0xf
    v_dot2c_f32_bf16_dpp v15, v19, v75 row_newbcast:12 row_mask:0xf bank_mask:0xf
    s_cbranch_vccnz L_pv4
    s_waitcnt vmcnt(4)
L_pv4:
    s_waitcnt vmcnt(5)
    buffer_load_dwordx4 v[68:71], v1, s[4:7], s28 offen offset:2048 nt
    v_dot2c_f32_bf16_dpp v8, v18, v76 row_newbcast:2 row_mask:0xf bank_mask:0xf
    v_dot2c_f32_bf16_dpp v9, v19, v76 row_newbcast:2 row_mask:0xf bank_mask:0xf
    v_dot2c_f32_bf16_dpp v10, v18, v77 row_newbcast:2 row_mask:0xf bank_mask:0xf
    v_dot2c_f32_bf16_dpp v11, v19, v77 row_newbcast:2 row_mask:0xf bank_mask:0xf
    v_dot2c_f32_bf16_dpp v12, v18, v78 row_newbcast:2 row_mask:0xf bank_mask:0xf
    v_dot2c_f32_bf16_dpp v13, v19, v78 row_newbcast:2 row_mask:0xf bank_mask:0xf
    v_dot2c_f32_bf16_dpp v14, v18, v79 row_newbcast:2 row_mask:0xf bank_mask:0xf
    v_dot2c_f32_bf16_dpp v15, v19, v79 row_newbcast:2 row_mask:0xf bank_mask:0xf
    s_cmp_lg_u32 s29, 1
    s_cbranch_scc1 L_l1
    v_add_f32 v20, v19, v24
    v_add_f32 v20, v20, v25
    v_add_f32 v20, v20, v26
    v_add_f32 v20, v20, v27
    v_add_f32 v20, v20, v28
    v_add_f32 v20, v20, v29
    v_add_f32 v20, v20, v30
    s_nop 1
    v_add_f32_dpp v20, v20, v20 row_ror:8 row_mask:0xf bank_mask:0xf
    s_nop 1
    v_add_f32_dpp v20, v20, v20 row_ror:4 row_mask:0xf bank_mask:0xf
    s_nop 1
    v_add_f32_dpp v20, v20, v20 row_ror:2 row_mask:0xf bank_mask:0xf
    s_nop 1
    v_add_f32_dpp v20, v20, v20 row_ror:1 row_mask:0xf bank_mask:0xf
    v_mov_b32 v22, v20
    s_lshl_b32 s33, s30, 3
    s_add_u32 s33, s33, s51
    v_permlane32_swap_b32 v20, v22
    v_mov_b32 v23, s33
    v_add_f32 v20, v20, v22
    v_mov_b32 v22, v20
    s_lshr_b32 s33, s51, 3
    v_mov_b32 v21, s33
    v_permlane16_swap_b32 v20, v22
    v_mov_b32 v46, 1
    v_add_f32 v17, v20, v22
    s_mov_b64 exec, 1
    ds_write_b64 v23, v[16:17] offset:4096
    ds_add_u32 v21, v46 offset:4224
    s_mov_b64 exec, -1
L_l1:
    s_cbranch_vccnz L_pv5
    s_waitcnt vmcnt(4)
L_pv5:
    s_waitcnt vmcnt(5)
    buffer_load_dwordx4 v[72:75], v1, s[4:7], s28 offen offset:3072 nt
    v_dot2c_f32_bf16_dpp v8, v18, v80 row_newbcast:10 row_mask:0xf bank_mask:0xf
    v_dot2c_f32_bf16_dpp v9, v19, v80 row_newbcast:10 row_mask:0xf bank_mask:0xf
    v_dot2c_f32_bf16_dpp v10, v18, v81 row_newbcast:10 row_mask:0xf bank_mask:0xf
    v_dot2c_f32_bf16_dpp v11, v19, v81 row_newbcast:10 row_mask:0xf bank_mask:0xf
    v_dot2c_f32_bf16_dpp v12, v18, v82 row_newbcast:10 row_mask:0xf bank_mask:0xf
    v_dot2c_f32_bf16_dpp v13, v19, v82 row_newbcast:10 row_mask:0xf bank_mask:0xf
    v_dot2c_f32_bf16_dpp v14, v18, v83 row_newbcast:10 row_mask:0xf bank_mask:0xf
    v_dot2c_f32_bf16_dpp v15, v19, v83 row_newbcast:10 row_mask:0xf bank_mask:0xf
    s_cbranch_vccnz L_pv6
    s_waitcnt vmcnt(4)
L_pv6:
    s_waitcnt vmcnt(5)
    s_add_u32 s28, s26, 98304
    buffer_load_dwordx4 v[76:79], v2, s[4:7], s28 offen offset:0 nt
    v_dot2c_f32_bf16_dpp v8, v18, v84 row_newbcast:6 row_mask:0xf bank_mask:0xf
    v_dot2c_f32_bf16_dpp v9, v19, v84 row_newbcast:6 row_mask:0xf bank_mask:0xf
    v_dot2c_f32_bf16_dpp v10, v18, v85 row_newbcast:6 row_mask:0xf bank_mask:0xf
    v_dot2c_f32_bf16_dpp v11, v19, v85 row_newbcast:6 row_mask:0xf bank_mask:0xf
    v_dot2c_f32_bf16_dpp v12, v18, v86 row_newbcast:6 row_mask:0xf bank_mask:0xf
    v_dot2c_f32_bf16_dpp v13, v19, v86 row_newbcast:6 row_mask:0xf bank_mask:0xf
    v_dot2c_f32_bf16_dpp v14, v18, v87 row_newbcast:6 row_mask:0xf bank_mask:0xf
    v_dot2c_f32_bf16_dpp v15, v19, v87 row_newbcast:6 row_mask:0xf bank_mask:0xf
    s_cbranch_vccnz L_pv7
    s_waitcnt vmcnt(4)
L_pv7:
    s_waitcnt vmcnt(5)
    buffer_load_dwordx4 v[80:83], v2, s[4:7], s28 offen offset:1024 nt
    v_dot2c_f32_bf16_dpp v8, v18, v88 row_newbcast:14 row_mask:0xf bank_mask:0xf
    v_dot2c_f32_bf16_dpp v9, v19, v88 row_newbcast:14 row_mask:0xf bank_mask:0xf
    v_dot2c_f32_bf16_dpp v10, v18, v89 row_newbcast:14 row_mask:0xf bank_mask:0xf
    v_dot2c_f32_bf16_dpp v11, v19, v89 row_newbcast:14 row_mask:0xf bank_mask:0xf
    v_dot2c_f32_bf16_dpp v12, v18, v90 row_newbcast:14 row_mask:0xf bank_mask:0xf
    v_dot2c_f32_bf16_dpp v13, v19, v90 row_newbcast:14 row_mask:0xf bank_mask:0xf
    v_dot2c_f32_bf16_dpp v14, v18, v91 row_newbcast:14 row_mask:0xf bank_mask:0xf
    v_dot2c_f32_bf16_dpp v15, v19, v91 row_newbcast:14 row_mask:0xf bank_mask:0xf
    s_waitcnt lgkmcnt(0)
    s_sub_u32 s48, s42, s44
    s_add_u32 s44, s44, 218
    s_cmp_lg_u32 s29, s46
    s_cbranch_scc1 L_av
    s_lshl_b32 s33, s48, 5
    s_add_u32 s33, s33, 1
    s_atomic_add s33, s[56:57], s47
L_av:
    s_cbranch_vccnz L_pv8
    s_waitcnt vmcnt(4)
L_pv8:
    s_waitcnt vmcnt(5)
    buffer_load_dwordx4 v[84:87], v2, s[4:7], s28 offen offset:2048 nt
    v_dot2c_f32_bf16_dpp v8, v18, v60 row_newbcast:1 row_mask:0xf bank_mask:0xf
    v_dot2c_f32_bf16_dpp v9, v19, v60 row_newbcast:1 row_mask:0xf bank_mask:0xf
    v_dot2c_f32_bf16_dpp v10, v18, v61 row_newbcast:1 row_mask:0xf bank_mask:0xf
    v_dot2c_f32_bf16_dpp v11, v19, v61 row_newbcast:1 row_mask:0xf bank_mask:0xf
    v_dot2c_f32_bf16_dpp v12, v18, v62 row_newbcast:1 row_mask:0xf bank_mask:0xf
    v_dot2c_f32_bf16_dpp v13, v19, v62 row_newbcast:1 row_mask:0xf bank_mask:0xf
    v_dot2c_f32_bf16_dpp v14, v18, v63 row_newbcast:1 row_mask:0xf bank_mask:0xf
    v_dot2c_f32_bf16_dpp v15, v19, v63 row_newbcast:1 row_mask:0xf bank_mask:0xf
    s_cbranch_vccnz L_pv9
    s_waitcnt vmcnt(4)
L_pv9:
    s_waitcnt vmcnt(5)
    buffer_load_dwordx4 v[88:91], v2, s[4:7], s28 offen offset:3072 nt
    v_dot2c_f32_bf16_dpp v8, v18, v64 row_newbcast:9 row_mask:0xf bank_mask:0xf
    v_dot2c_f32_bf16_dpp v9, v19, v64 row_newbcast:9 row_mask:0xf bank_mask:0xf
    v_dot2c_f32_bf16_dpp v10, v18, v65 row_newbcast:9 row_mask:0xf bank_mask:0xf
    v_dot2c_f32_bf16_dpp v11, v19, v65 row_newbcast:9 row_mask:0xf bank_mask:0xf
    v_dot2c_f32_bf16_dpp v12, v18, v66 row_newbcast:9 row_mask:0xf bank_mask:0xf
    v_dot2c_f32_bf16_dpp v13, v19, v66 row_newbcast:9 row_mask:0xf bank_mask:0xf
    v_dot2c_f32_bf16_dpp v14, v18, v67 row_newbcast:9 row_mask:0xf bank_mask:0xf
    v_dot2c_f32_bf16_dpp v15, v19, v67 row_newbcast:9 row_mask:0xf bank_mask:0xf
    s_cmp_lg_u32 s29, 5
    s_cbranch_scc1 L_f1
    s_lshr_b32 s33, s51, 3
    v_mov_b32 v21, s33
    v_mov_b32 v23, s51
L_f0:
    ds_read_b32 v20, v21 offset:4224
    ds_read_b128 v[32:35], v23 offset:4096
    ds_read_b128 v[36:39], v23 offset:4112
    s_waitcnt lgkmcnt(0)
    v_readfirstlane_b32 s33, v20
    s_cmp_lg_u32 s33, 4
    s_cbranch_scc1 L_f0
    v_max_f32 v20, v32, v34
    v_max3_f32 v20, v20, v36, v38
    v_sub_f32 v32, v32, v20
    v_sub_f32 v34, v34, v20
    v_sub_f32 v36, v36, v20
    v_sub_f32 v38, v38, v20
    v_sub_f32 v46, v16, v20
    v_exp_f32 v32, v32
    v_exp_f32 v34, v34
    v_exp_f32 v36, v36
    v_exp_f32 v38, v38
    v_exp_f32 v46, v46
    v_mul_f32 v20, v32, v33
    v_fmac_f32 v20, v34, v35
    v_fmac_f32 v20, v36, v37
    v_fmac_f32 v20, v38, v39
    v_rcp_f32 v20, v20
    s_nop 0
    v_mul_f32 v46, v46, v20
L_f1:
    s_cbranch_vccnz L_pv10
    s_waitcnt vmcnt(4)
L_pv10:
    s_waitcnt vmcnt(5)
    buffer_load_dwordx4 v[60:63], v1, s[8:11], s27 offen offset:0 nt
    v_dot2c_f32_bf16_dpp v8, v18, v68 row_newbcast:5 row_mask:0xf bank_mask:0xf
    v_dot2c_f32_bf16_dpp v9, v19, v68 row_newbcast:5 row_mask:0xf bank_mask:0xf
    v_dot2c_f32_bf16_dpp v10, v18, v69 row_newbcast:5 row_mask:0xf bank_mask:0xf
    v_dot2c_f32_bf16_dpp v11, v19, v69 row_newbcast:5 row_mask:0xf bank_mask:0xf
    v_dot2c_f32_bf16_dpp v12, v18, v70 row_newbcast:5 row_mask:0xf bank_mask:0xf
    v_dot2c_f32_bf16_dpp v13, v19, v70 row_newbcast:5 row_mask:0xf bank_mask:0xf
    v_dot2c_f32_bf16_dpp v14, v18, v71 row_newbcast:5 row_mask:0xf bank_mask:0xf
    v_dot2c_f32_bf16_dpp v15, v19, v71 row_newbcast:5 row_mask:0xf bank_mask:0xf
    s_cbranch_vccnz L_pv11
    s_waitcnt vmcnt(4)
L_pv11:
    s_waitcnt vmcnt(5)
    buffer_load_dwordx4 v[64:67], v1, s[8:11], s27 offen offset:1024 nt
    v_dot2c_f32_bf16_dpp v8, v18, v72 row_newbcast:13 row_mask:0xf bank_mask:0xf
    v_dot2c_f32_bf16_dpp v9, v19, v72 row_newbcast:13 row_mask:0xf bank_mask:0xf
    v_dot2c_f32_bf16_dpp v10, v18, v73 row_newbcast:13 row_mask:0xf bank_mask:0xf
    v_dot2c_f32_bf16_dpp v11, v19, v73 row_newbcast:13 row_mask:0xf bank_mask:0xf
    v_dot2c_f32_bf16_dpp v12, v18, v74 row_newbcast:13 row_mask:0xf bank_mask:0xf
    v_dot2c_f32_bf16_dpp v13, v19, v74 row_newbcast:13 row_mask:0xf bank_mask:0xf
    v_dot2c_f32_bf16_dpp v14, v18, v75 row_newbcast:13 row_mask:0xf bank_mask:0xf
    v_dot2c_f32_bf16_dpp v15, v19, v75 row_newbcast:13 row_mask:0xf bank_mask:0xf
    s_cmp_lg_u32 s29, 4
    s_cbranch_scc1 L_bv
    buffer_load_dword v47, off, s[56:59], s47 sc1
    s_add_u32 s47, s47, 64
L_bv:
    s_cmp_lg_u32 s29, 5
    s_cbranch_scc1 L_cv
    v_readfirstlane_b32 s33, v47
    s_and_b32 s34, s33, 31
    s_cmp_eq_u32 s34, 8
    s_cbranch_scc0 L_cv
    s_sub_u32 s34, s33, s52
    s_ashr_i32 s34, s34, 3
    s_cmp_lt_i32 s34, -16384
    s_cselect_b32 s34, 0, s34
    s_max_i32 s34, s34, -2560
    s_min_i32 s53, s34, 2560
    s_mov_b32 s52, s33
    s_mul_i32 s34, s53, 2
    s_add_u32 s45, s33, s34
L_cv:
    s_add_u32 s45, s45, s53
    s_lshl_b32 s48, s48, 8
    s_sub_u32 s48, s48, s45
    s_cmp_gt_i32 s48, 6400
    s_cselect_b64 vcc, -1, 0
    s_cbranch_vccnz L_pv12
    s_waitcnt vmcnt(4)
L_pv12:
    s_waitcnt vmcnt(5)
    buffer_load_dwordx4 v[68:71], v1, s[8:11], s27 offen offset:2048 nt
    v_dot2c_f32_bf16_dpp v8, v18, v76 row_newbcast:3 row_mask:0xf bank_mask:0xf
    v_dot2c_f32_bf16_dpp v9, v19, v76 row_newbcast:3 row_mask:0xf bank_mask:0xf
    v_dot2c_f32_bf16_dpp v10, v18, v77 row_newbcast:3 row_mask:0xf bank_mask:0xf
    v_dot2c_f32_bf16_dpp v11, v19, v77 row_newbcast:3 row_mask:0xf bank_mask:0xf
    v_dot2c_f32_bf16_dpp v12, v18, v78 row_newbcast:3 row_mask:0xf bank_mask:0xf
    v_dot2c_f32_bf16_dpp v13, v19, v78 row_newbcast:3 row_mask:0xf bank_mask:0xf
    v_dot2c_f32_bf16_dpp v14, v18, v79 row_newbcast:3 row_mask:0xf bank_mask:0xf
    v_dot2c_f32_bf16_dpp v15, v19, v79 row_newbcast:3 row_mask:0xf bank_mask:0xf
    s_cbranch_vccnz L_pv13
    s_waitcnt vmcnt(4)
L_pv13:
    s_waitcnt vmcnt(5)
    buffer_load_dwordx4 v[72:75], v1, s[8:11], s27 offen offset:3072 nt
    v_dot2c_f32_bf16_dpp v8, v18, v80 row_newbcast:11 row_mask:0xf bank_mask:0xf
    v_dot2c_f32_bf16_dpp v9, v19, v80 row_newbcast:11 row_mask:0xf bank_mask:0xf
    v_dot2c_f32_bf16_dpp v10, v18, v81 row_newbcast:11 row_mask:0xf bank_mask:0xf
    v_dot2c_f32_bf16_dpp v11, v19, v81 row_newbcast:11 row_mask:0xf bank_mask:0xf
    v_dot2c_f32_bf16_dpp v12, v18, v82 row_newbcast:11 row_mask:0xf bank_mask:0xf
    v_dot2c_f32_bf16_dpp v13, v19, v82 row_newbcast:11 row_mask:0xf bank_mask:0xf
    v_dot2c_f32_bf16_dpp v14, v18, v83 row_newbcast:11 row_mask:0xf bank_mask:0xf
    v_dot2c_f32_bf16_dpp v15, v19, v83 row_newbcast:11 row_mask:0xf bank_mask:0xf
    s_cbranch_vccnz L_pv14
    s_waitcnt vmcnt(4)
L_pv14:
    s_waitcnt vmcnt(5)
    s_add_u32 s28, s27, 32768
    buffer_load_dwordx4 v[76:79], v2, s[8:11], s28 offen offset:0 nt
    v_dot2c_f32_bf16_dpp v8, v18, v84 row_newbcast:7 row_mask:0xf bank_mask:0xf
    v_dot2c_f32_bf16_dpp v9, v19, v84 row_newbcast:7 row_mask:0xf bank_mask:0xf
    v_dot2c_f32_bf16_dpp v10, v18, v85 row_newbcast:7 row_mask:0xf bank_mask:0xf
    v_dot2c_f32_bf16_dpp v11, v19, v85 row_newbcast:7 row_mask:0xf bank_mask:0xf
    v_dot2c_f32_bf16_dpp v12, v18, v86 row_newbcast:7 row_mask:0xf bank_mask:0xf
    v_dot2c_f32_bf16_dpp v13, v19, v86 row_newbcast:7 row_mask:0xf bank_mask:0xf
    v_dot2c_f32_bf16_dpp v14, v18, v87 row_newbcast:7 row_mask:0xf bank_mask:0xf
    v_dot2c_f32_bf16_dpp v15, v19, v87 row_newbcast:7 row_mask:0xf bank_mask:0xf
    s_cbranch_vccnz L_pv15
    s_waitcnt vmcnt(4)
L_pv15:
    s_waitcnt vmcnt(5)
    buffer_load_dwordx4 v[80:83], v2, s[8:11], s28 offen offset:1024 nt
    v_dot2c_f32_bf16_dpp v8, v18, v88 row_newbcast:15 row_mask:0xf bank_mask:0xf
    v_dot2c_f32_bf16_dpp v9, v19, v88 row_newbcast:15 row_mask:0xf bank_mask:0xf
    v_dot2c_f32_bf16_dpp v10, v18, v89 row_newbcast:15 row_mask:0xf bank_mask:0xf
    v_dot2c_f32_bf16_dpp v11, v19, v89 row_newbcast:15 row_mask:0xf bank_mask:0xf
    v_dot2c_f32_bf16_dpp v12, v18, v90 row_newbcast:15 row_mask:0xf bank_mask:0xf
    v_dot2c_f32_bf16_dpp v13, v19, v90 row_newbcast:15 row_mask:0xf bank_mask:0xf
    v_dot2c_f32_bf16_dpp v14, v18, v91 row_newbcast:15 row_mask:0xf bank_mask:0xf
    v_dot2c_f32_bf16_dpp v15, v19, v91 row_newbcast:15 row_mask:0xf bank_mask:0xf
    s_mov_b64 s[4:5], s[8:9]
    s_mov_b32 s26, s27
    s_cmp_lg_u32 s29, 8
    s_cbranch_scc1 L_v
    s_lshl_b32 s33, s30, 9
    s_lshl_b32 s34, s37, 11
    v_permlane32_swap_b32 v8, v12
    v_permlane32_swap_b32 v9, v13
    v_permlane32_swap_b32 v10, v14
    v_permlane32_swap_b32 v11, v15
    v_add_u32 v22, s34, v57
    s_lshr_b32 s34, s51, 3
    v_add_f32 v8, v8, v12
    v_add_f32 v9, v9, v13
    v_add_f32 v10, v10, v14
    v_add_f32 v11, v11, v15
    v_add_u32 v23, s33, v22
    v_mov_b32 v20, s34
    v_permlane16_swap_b32 v8, v10
    v_permlane16_swap_b32 v9, v11
    v_mov_b32 v21, 1
    v_add_f32 v8, v8, v10
    v_add_f32 v9, v9, v11
    v_mul_f32 v8, v8, v46
    v_mul_f32 v9, v9, v46
    ds_write_b64 v23, v[8:9]
    s_mov_b64 exec, 1
    ds_add_rtn_u32 v21, v20, v21 offset:4228
    s_mov_b64 exec, -1
    s_mov_b32 s29, 0
    s_mov_b32 s32, s31
    v_mov_b32 v10, 0
    v_mov_b32 v11, 0
    v_mov_b32 v12, 0
    v_mov_b32 v13, 0
    v_mov_b32 v14, 0
    v_mov_b32 v15, 0
    s_waitcnt lgkmcnt(0)
    v_readfirstlane_b32 s33, v21
    v_mov_b32 v8, 0
    v_mov_b32 v9, 0
    s_cmp_lg_u32 s33, 3
    s_cbranch_scc1 L_next
    ds_read2st64_b64 v[48:51], v22 offset0:0 offset1:1
    ds_read2st64_b64 v[52:55], v22 offset0:2 offset1:3
    s_waitcnt lgkmcnt(1)
    v_add_f32 v20, v48, v50
    v_add_f32 v21, v49, v51
    s_waitcnt lgkmcnt(0)
    v_add_f32 v22, v52, v54
    v_add_f32 v23, v53, v55
    v_add_f32 v20, v20, v22
    v_add_f32 v21, v21, v23
    v_cvt_pk_bf16_f32 v20, v20, v21
    buffer_store_dword v20, v56, s[16:19], s36 offen
L_next:
    s_cmp_lg_u32 s37, 0
    s_cbranch_scc1 L_fin
    s_add_u32 s36, s36, 256
    s_mov_b32 s37, 1
    s_mov_b32 s51, 64
    s_branch L_k
L_fin:
L_end:
    s_endpgm
.section .rodata,"a"
.p2align 6
.amdhsa_kernel standalone__softmax_full_bidir__sampling_kernel
  .amdhsa_next_free_vgpr 92
  .amdhsa_next_free_sgpr 60
  .amdhsa_accum_offset 92
  .amdhsa_group_segment_fixed_size 0
  .amdhsa_kernarg_size 48
  .amdhsa_user_sgpr_count 2
  .amdhsa_user_sgpr_kernarg_segment_ptr 1
  .amdhsa_system_sgpr_workgroup_id_x 1
.end_amdhsa_kernel
```
